```python
import torch

def _softmax(x, axis=-1):
    return torch.softmax(x, dim=axis)
def _gelu(x):
    return torch.nn.functional.gelu(x, approximate="tanh")
def _silu(x):
    return torch.nn.functional.silu(x)
def _sigmoid(x):
    return torch.sigmoid(x)
def _layernorm(x, axis=-1, eps=1e-5):
    m = x.mean(dim=axis, keepdim=True)
    v = x.var(dim=axis, keepdim=True, unbiased=False)
    return (x - m) / torch.sqrt(v + eps)
def _scatter_add(tgt, idx, src, axis=0):
    return tgt.clone().index_add_(axis, idx, src)
def _segment_sum(src, seg, n):
    out = torch.zeros((n,) + src.shape[1:], dtype=src.dtype)
    return out.index_add_(0, seg, src)
def _pad(x, pw):
    flat = tuple(v for pair in reversed(pw) for v in pair)
    return torch.nn.functional.pad(x, flat)

kernel_name = 'standalone__sparse_matmul_formats_ell__sparse_mat'

def setup_inputs():

    _w = (lambda a: (lambda t: t.to(torch.bfloat16) if t.is_floating_point() else t)(torch.as_tensor(a)))
    M = N = 65536
    D = 64
    K = max(1, int(0.001 * N))
    col_idx = (lambda lo, hi, *s: torch.randint(lo, hi, s))(0, N, M, K)
    vals = (lambda *s: torch.randn(*s, dtype=torch.bfloat16) * 0.05)(M, K)
    lengths = (lambda lo, hi, *s: torch.randint(lo, hi, s))(1, K + 1, M)
    mask = (torch.arange(K)[None, :] < lengths[:, None]).to(vals.dtype)
    vals = vals * mask
    b = (lambda *s: torch.randn(*s, dtype=torch.bfloat16) * 0.05)(N, D)
    return {
        "vals": _w(vals),
        "col_idx": _w(col_idx),
        "b": _w(b),
    }

def reference(vals, col_idx, b):
    gathered = b[col_idx]
    return torch.einsum("mk,mkd->md", vals, gathered)
```

```asm
; @launch grid=(512,1,1) block=(1024,1,1) lds=81920
.amdgcn_target "amdgcn-amd-amdhsa--gfx950"
.text
.globl standalone__sparse_matmul_formats_ell__sparse_mat_kernel
.p2align 8
.type standalone__sparse_matmul_formats_ell__sparse_mat_kernel,@function
standalone__sparse_matmul_formats_ell__sparse_mat_kernel:
s_cmp_ge_u32 s2, 512
s_cbranch_scc1 L_end
s_load_dwordx4 s[4:7], s[0:1], 0
s_load_dwordx4 s[60:63], s[0:1], 16
s_setprio 3
v_and_b32 v1, 63, v0
v_lshrrev_b32 v10, 6, v0
v_lshlrev_b32 v11, 4, v1
v_readfirstlane_b32 s29, v10
v_lshlrev_b32 v9, 3, v1
s_mul_i32 s28, s2, 16
s_add_u32 s28, s28, s29
s_mul_i32 s30, s28, 2080
s_mul_i32 s31, s28, 1040
s_and_b32 s34, s28, 7
s_lshl_b32 s35, s34, 4
v_subrev_u32 v12, s35, v9
v_lshlrev_b32 v8, 1, v1
v_add_u32 v13, 512, v12
s_sub_u32 s35, 1024, s35
v_lshlrev_b32 v11, 1, v12
v_add_u32 v8, s35, v8
v_lshlrev_b32 v7, 1, v13
v_lshlrev_b32 v6, 1, v8
s_movk_i32 s10, 1040
s_mov_b32 s11, 0x20000
s_movk_i32 s14, 2080
s_mov_b32 s15, 0x20000
s_waitcnt lgkmcnt(0)
s_add_u32 s8, s4, s31
s_addc_u32 s9, s5, 0
s_add_u32 s12, s6, s30
s_addc_u32 s13, s7, 0
s_and_b32 s9, s9, 0xffff
s_and_b32 s13, s13, 0xffff
buffer_load_dwordx2 v[26:27], v12, s[8:11], 0 offen nt
buffer_load_dwordx2 v[28:29], v13, s[8:11], 0 offen nt
buffer_load_ushort v30, v8, s[8:11], 0 offen nt
v_mov_b32 v16, v11
v_mov_b32 v20, v7
v_mov_b32 v24, v6
s_mul_i32 s31, s34, 129152
s_mov_b32 s18, 0x800000
s_mov_b32 s19, 0x20000
s_mov_b32 s22, 0x800000
s_mov_b32 s23, 0x20000
s_mov_b32 s16, s60
s_and_b32 s17, s61, 0xffff
s_mov_b32 s20, s62
s_and_b32 s21, s63, 0xffff
s_mul_i32 s3, s29, 5120
v_mov_b32 v14, 0
v_mov_b32 v15, 0
v_add_u32 v9, s3, v9
ds_write_b64 v9, v[14:15]
v_lshrrev_b32 v9, 4, v1
v_and_b32 v10, 14, v1
v_lshl_add_u32 v5, v10, 3, s3
v_lshl_add_u32 v5, v9, 7, v5
v_and_b32 v8, 32, v1
v_lshl_add_u32 v3, v8, 2, s3
v_and_b32 v8, 4, v1
v_lshl_add_u32 v3, v8, 6, v3
v_and_b32 v8, 1, v9
v_lshl_add_u32 v3, v8, 3, v3
v_and_b32 v8, 3, v1
v_lshl_add_u32 v3, v8, 1, v3
v_and_b32 v8, 7, v1
v_lshl_add_u32 v4, v8, 5, s3
v_lshl_add_u32 v4, v9, 3, v4
v_and_b32 v2, 15, v1
v_lshlrev_b32 v2, 2, v2
s_add_u32 s32, s3, 4864
s_and_b32 s34, s2, 7
s_lshl_b32 s38, s34, 20
s_lshl_b32 s34, s34, 3
v_add_u32 v6, s34, v1
v_and_b32 v6, 63, v6
v_lshl_add_u32 v6, v6, 2, s32
ds_write_b32 v6, v14
v_mov_b32 v7, 0
v_mul_u32_u24 v8, 64576, v1
v_subrev_u32 v8, s31, v8
s_mov_b32 s39, 0x700000
v_and_b32 v33, s39, v8
v_add_u32 v35, 16144, v8
v_and_b32 v35, s39, v35
v_add_u32 v37, 32288, v8
v_and_b32 v37, s39, v37
v_add_u32 v39, 48432, v8
v_and_b32 v39, s39, v39
v_add_u32 v41, 4132864, v8
v_and_b32 v41, s39, v41
v_add_u32 v43, 4149008, v8
v_and_b32 v43, s39, v43
v_add_u32 v45, 4165152, v8
v_and_b32 v45, s39, v45
v_add_u32 v47, 4181296, v8
v_and_b32 v47, s39, v47
v_mov_b32 v49, s39
s_mov_b32 s36, 0x0c060100
s_mov_b32 s37, 0x0c060302
v_bfe_i32 v8, v1, 0, 1
v_and_b32 v8, 0x5555, v8
v_or_b32 v11, 0x8888, v8
v_mov_b32 v9, 8
v_mov_b32 v10, s32
s_movk_i32 s39, 0xfc
v_mov_b32 v14, s18
v_lshl_add_u32 v8, v1, 3, s3
ds_write_b64 v8, v[14:15] offset:512
s_mov_b32 s34, 0x7fff7fff
s_waitcnt vmcnt(2)
v_or_b32 v8, v26, v27
v_and_b32 v8, s34, v8
v_cmp_ne_u32 vcc, 0, v8
s_mov_b64 exec, vcc
buffer_load_dwordx4 v[16:19], v16, s[12:15], 0 offen nt
s_mov_b64 exec, -1
s_waitcnt vmcnt(2)
v_or_b32 v8, v28, v29
v_and_b32 v8, s34, v8
v_cmp_ne_u32 vcc, 0, v8
s_mov_b64 exec, vcc
buffer_load_dwordx4 v[20:23], v20, s[12:15], 0 offen nt
s_mov_b64 exec, -1
s_waitcnt vmcnt(2)
v_perm_b32 v49, v49, v30, s36
v_cmp_neq_f16_e64 s[56:57], 0, v49
s_mov_b64 exec, s[56:57]
buffer_load_dword v24, v24, s[12:15], 0 offen nt
s_mov_b64 exec, -1
v_perm_b32 v33, v33, v26, s36
v_cmp_neq_f16_e64 s[40:41], 0, v33
v_perm_b32 v35, v35, v26, s37
v_cmp_neq_f16_e64 s[42:43], 0, v35
v_perm_b32 v37, v37, v27, s36
v_cmp_neq_f16_e64 s[44:45], 0, v37
v_perm_b32 v39, v39, v27, s37
v_cmp_neq_f16_e64 s[46:47], 0, v39
v_perm_b32 v41, v41, v28, s36
v_cmp_neq_f16_e64 s[48:49], 0, v41
v_perm_b32 v43, v43, v28, s37
v_cmp_neq_f16_e64 s[50:51], 0, v43
v_perm_b32 v45, v45, v29, s36
v_cmp_neq_f16_e64 s[52:53], 0, v45
v_perm_b32 v47, v47, v29, s37
v_cmp_neq_f16_e64 s[54:55], 0, v47
s_waitcnt vmcnt(2)
v_lshlrev_b32_sdwa v32, 7, v16 dst_sel:DWORD dst_unused:UNUSED_PAD src0_sel:DWORD src1_sel:WORD_0
v_lshrrev_b32 v16, 8, v16
v_and_or_b32 v16, v16, s39, v10
v_lshlrev_b32_sdwa v34, 7, v17 dst_sel:DWORD dst_unused:UNUSED_PAD src0_sel:DWORD src1_sel:WORD_0
v_lshrrev_b32 v17, 8, v17
v_and_or_b32 v17, v17, s39, v10
v_lshlrev_b32_sdwa v36, 7, v18 dst_sel:DWORD dst_unused:UNUSED_PAD src0_sel:DWORD src1_sel:WORD_0
v_lshrrev_b32 v18, 8, v18
v_and_or_b32 v18, v18, s39, v10
v_lshlrev_b32_sdwa v38, 7, v19 dst_sel:DWORD dst_unused:UNUSED_PAD src0_sel:DWORD src1_sel:WORD_0
v_lshrrev_b32 v19, 8, v19
v_and_or_b32 v19, v19, s39, v10
s_mov_b64 exec, s[40:41]
ds_add_u32 v16, v9
s_mov_b64 exec, s[42:43]
ds_add_u32 v17, v9
s_mov_b64 exec, s[44:45]
ds_add_u32 v18, v9
s_mov_b64 exec, s[46:47]
ds_add_u32 v19, v9
s_mov_b64 exec, -1
s_waitcnt vmcnt(1)
v_lshlrev_b32_sdwa v40, 7, v20 dst_sel:DWORD dst_unused:UNUSED_PAD src0_sel:DWORD src1_sel:WORD_0
v_lshrrev_b32 v20, 8, v20
v_and_or_b32 v20, v20, s39, v10
v_lshlrev_b32_sdwa v42, 7, v21 dst_sel:DWORD dst_unused:UNUSED_PAD src0_sel:DWORD src1_sel:WORD_0
v_lshrrev_b32 v21, 8, v21
v_and_or_b32 v21, v21, s39, v10
v_lshlrev_b32_sdwa v44, 7, v22 dst_sel:DWORD dst_unused:UNUSED_PAD src0_sel:DWORD src1_sel:WORD_0
v_lshrrev_b32 v22, 8, v22
v_and_or_b32 v22, v22, s39, v10
v_lshlrev_b32_sdwa v46, 7, v23 dst_sel:DWORD dst_unused:UNUSED_PAD src0_sel:DWORD src1_sel:WORD_0
v_lshrrev_b32 v23, 8, v23
v_and_or_b32 v23, v23, s39, v10
s_mov_b64 exec, s[48:49]
ds_add_u32 v20, v9
s_mov_b64 exec, s[50:51]
ds_add_u32 v21, v9
s_mov_b64 exec, s[52:53]
ds_add_u32 v22, v9
s_mov_b64 exec, s[54:55]
ds_add_u32 v23, v9
s_mov_b64 exec, -1
s_waitcnt vmcnt(0)
v_lshlrev_b32_sdwa v48, 7, v24 dst_sel:DWORD dst_unused:UNUSED_PAD src0_sel:DWORD src1_sel:WORD_0
v_lshrrev_b32 v24, 8, v24
v_and_or_b32 v24, v24, s39, v10
s_mov_b64 exec, s[56:57]
ds_add_u32 v24, v9
s_mov_b64 exec, -1
ds_read_b32 v26, v6
s_add_u32 s35, s3, 512
s_waitcnt lgkmcnt(0)
v_mov_b32 v27, v26
s_nop 1
v_add_u32_dpp v27, v27, v27 row_shr:1 row_mask:0xf bank_mask:0xf bound_ctrl:0
s_nop 1
v_add_u32_dpp v27, v27, v27 row_shr:2 row_mask:0xf bank_mask:0xf bound_ctrl:0
s_nop 1
v_add_u32_dpp v27, v27, v27 row_shr:4 row_mask:0xf bank_mask:0xf bound_ctrl:0
s_nop 1
v_add_u32_dpp v27, v27, v27 row_shr:8 row_mask:0xf bank_mask:0xf bound_ctrl:0
s_nop 1
v_add_u32_dpp v27, v27, v27 row_bcast:15 row_mask:0xa bank_mask:0xf
s_nop 1
v_add_u32_dpp v27, v27, v27 row_bcast:31 row_mask:0xc bank_mask:0xf
s_nop 1
v_readlane_b32 s34, v27, 63
v_sub_u32 v26, v27, v26
s_sub_u32 s30, 0, s34
s_and_b32 s30, s30, 255
s_add_u32 s35, s35, s30
s_lshr_b32 s30, s30, 5
v_add_u32 v26, s35, v26
ds_write_b32 v6, v26
s_add_u32 s32, s34, 255
s_lshr_b32 s32, s32, 8
s_mov_b64 exec, s[40:41]
ds_add_rtn_u32 v16, v16, v9
s_mov_b64 exec, s[42:43]
ds_add_rtn_u32 v17, v17, v9
s_mov_b64 exec, s[44:45]
ds_add_rtn_u32 v18, v18, v9
s_mov_b64 exec, s[46:47]
ds_add_rtn_u32 v19, v19, v9
s_mov_b64 exec, s[48:49]
ds_add_rtn_u32 v20, v20, v9
s_mov_b64 exec, s[50:51]
ds_add_rtn_u32 v21, v21, v9
s_mov_b64 exec, s[52:53]
ds_add_rtn_u32 v22, v22, v9
s_mov_b64 exec, s[54:55]
ds_add_rtn_u32 v23, v23, v9
s_mov_b64 exec, s[56:57]
ds_add_rtn_u32 v24, v24, v9
s_waitcnt lgkmcnt(5)
s_mov_b64 exec, s[40:41]
ds_write_b64 v16, v[32:33]
s_mov_b64 exec, s[42:43]
ds_write_b64 v17, v[34:35]
s_mov_b64 exec, s[44:45]
ds_write_b64 v18, v[36:37]
s_mov_b64 exec, s[46:47]
ds_write_b64 v19, v[38:39]
s_waitcnt lgkmcnt(4)
s_mov_b64 exec, s[48:49]
ds_write_b64 v20, v[40:41]
s_mov_b64 exec, s[50:51]
ds_write_b64 v21, v[42:43]
s_mov_b64 exec, s[52:53]
ds_write_b64 v22, v[44:45]
s_mov_b64 exec, s[54:55]
ds_write_b64 v23, v[46:47]
s_mov_b64 exec, s[56:57]
ds_write_b64 v24, v[48:49]
s_mov_b64 exec, -1
ds_read_b64 v[8:9], v4 offset:512
v_mov_b32 v16, 0
v_mov_b32 v17, 0
v_mov_b32 v18, 0
v_mov_b32 v19, 0
v_mov_b32 v20, 0
v_mov_b32 v21, 0
v_mov_b32 v22, 0
v_mov_b32 v23, 0
s_mov_b32 s33, s32
s_mov_b32 s40, 0
s_mov_b32 s4, s38
s_mov_b32 s5, s28
s_mov_b32 s6, s33
s_mov_b32 s12, s30
s_cmp_eq_u32 s32, 0
s_cbranch_scc1 L_store
s_waitcnt lgkmcnt(0)
v_readlane_b32 s8, v8, 63
s_mov_b32 s13, -1
s_cmp_le_u32 s6, 2
s_cbranch_scc1 L_sga
s_mov_b32 s13, 65535
s_nop 1
s_buffer_load_dwordx16 s[24:39], s[16:19], s8 offset:0
s_buffer_load_dwordx16 s[40:55], s[16:19], s8 offset:64
L_sga:
v_mov_b32 v28, 0
v_mov_b32 v29, 0
v_mov_b32 v30, 0
v_mov_b32 v31, 0
v_mov_b32 v32, 0
v_mov_b32 v33, 0
v_mov_b32 v34, 0
v_mov_b32 v35, 0
v_mov_b32 v36, 0
v_mov_b32 v37, 0
v_mov_b32 v38, 0
v_mov_b32 v39, 0
v_mov_b32 v40, 0
v_mov_b32 v41, 0
v_mov_b32 v42, 0
v_mov_b32 v43, 0
s_bitcmp1_b32 s12, 2
s_cbranch_scc1 L_sk4
s_cmp_eq_u32 s12, 0
s_cbranch_scc1 L_is0
s_cmp_eq_u32 s12, 1
s_cbranch_scc1 L_is1
s_cmp_eq_u32 s12, 2
s_cbranch_scc1 L_is2
s_branch L_is3
L_sk4:
s_cmp_eq_u32 s12, 4
s_cbranch_scc1 L_is4
s_cmp_eq_u32 s12, 5
s_cbranch_scc1 L_is5
s_cmp_eq_u32 s12, 6
s_cbranch_scc1 L_is6
s_branch L_is7
L_loop:
v_readlane_b32 s8, v8, 63
s_mov_b32 s13, -1
s_cmp_le_u32 s6, 2
s_cbranch_scc1 L_sgb
s_mov_b32 s13, 65535
s_nop 1
s_buffer_load_dwordx16 s[24:39], s[16:19], s8 offset:0
s_buffer_load_dwordx16 s[40:55], s[16:19], s8 offset:64
L_sgb:
s_sub_u32 s7, s8, s4
s_bfe_u32 s7, s7, 327698
s_bitcmp1_b32 0xfff80000, s7
s_cbranch_scc1 L_ph
s_setprio 3
s_bitcmp1_b32 0xf807fc00, s7
s_cbranch_scc0 L_pe
s_setprio 2
s_branch L_pe
L_ph:
s_setprio 1
s_bitcmp1_b32 0xf807fc00, s7
s_cbranch_scc0 L_pe
s_setprio 0
L_pe:
L_is0:
v_add_u32_dpp v12, v8, v2 row_newbcast:0 row_mask:0xf bank_mask:0xf
buffer_load_dword v28, v12, s[16:19], 0 offen
buffer_load_dword v36, v12, s[16:19], 0 offen offset:64
L_is1:
v_add_u32_dpp v13, v8, v2 row_newbcast:1 row_mask:0xf bank_mask:0xf
buffer_load_dword v29, v13, s[16:19], 0 offen
buffer_load_dword v37, v13, s[16:19], 0 offen offset:64
L_is2:
v_add_u32_dpp v12, v8, v2 row_newbcast:2 row_mask:0xf bank_mask:0xf
buffer_load_dword v30, v12, s[16:19], 0 offen
buffer_load_dword v38, v12, s[16:19], 0 offen offset:64
L_is3:
v_add_u32_dpp v13, v8, v2 row_newbcast:3 row_mask:0xf bank_mask:0xf
buffer_load_dword v31, v13, s[16:19], 0 offen
buffer_load_dword v39, v13, s[16:19], 0 offen offset:64
L_is4:
v_add_u32_dpp v12, v8, v2 row_newbcast:4 row_mask:0xf bank_mask:0xf
buffer_load_dword v32, v12, s[16:19], 0 offen
buffer_load_dword v40, v12, s[16:19], 0 offen offset:64
L_is5:
v_add_u32_dpp v13, v8, v2 row_newbcast:5 row_mask:0xf bank_mask:0xf
buffer_load_dword v33, v13, s[16:19], 0 offen
buffer_load_dword v41, v13, s[16:19], 0 offen offset:64
L_is6:
v_add_u32_dpp v12, v8, v2 row_newbcast:6 row_mask:0xf bank_mask:0xf
buffer_load_dword v34, v12, s[16:19], 0 offen
buffer_load_dword v42, v12, s[16:19], 0 offen offset:64
L_is7:
v_add_u32_dpp v13, v8, v2 row_newbcast:7 row_mask:0xf bank_mask:0xf
s_mov_b32 exec_hi, s13
buffer_load_dword v35, v13, s[16:19], 0 offen
buffer_load_dword v43, v13, s[16:19], 0 offen offset:64
s_mov_b64 exec, -1
v_add_u32_sdwa v6, v3, v9 dst_sel:DWORD dst_unused:UNUSED_PAD src0_sel:DWORD src1_sel:WORD_1
ds_write_b16 v6, v9
ds_read_b128 v[24:27], v5
ds_write_b16 v6, v7
ds_read_b64 v[8:9], v4 offset:768
v_add_u32 v4, 256, v4
s_cmp_eq_u32 s13, -1
s_cbranch_scc1 L_sgw
s_waitcnt lgkmcnt(0)
v_writelane_b32 v35, s24, 48
v_writelane_b32 v35, s25, 49
v_writelane_b32 v35, s26, 50
v_writelane_b32 v35, s27, 51
v_writelane_b32 v35, s28, 52
v_writelane_b32 v35, s29, 53
v_writelane_b32 v35, s30, 54
v_writelane_b32 v35, s31, 55
v_writelane_b32 v35, s32, 56
v_writelane_b32 v35, s33, 57
v_writelane_b32 v35, s34, 58
v_writelane_b32 v35, s35, 59
v_writelane_b32 v35, s36, 60
v_writelane_b32 v35, s37, 61
v_writelane_b32 v35, s38, 62
v_writelane_b32 v35, s39, 63
v_writelane_b32 v43, s40, 48
v_writelane_b32 v43, s41, 49
v_writelane_b32 v43, s42, 50
v_writelane_b32 v43, s43, 51
v_writelane_b32 v43, s44, 52
v_writelane_b32 v43, s45, 53
v_writelane_b32 v43, s46, 54
v_writelane_b32 v43, s47, 55
v_writelane_b32 v43, s48, 56
v_writelane_b32 v43, s49, 57
v_writelane_b32 v43, s50, 58
v_writelane_b32 v43, s51, 59
v_writelane_b32 v43, s52, 60
v_writelane_b32 v43, s53, 61
v_writelane_b32 v43, s54, 62
v_writelane_b32 v43, s55, 63
L_sgw:
s_sub_u32 s6, s6, 1
s_sub_u32 s14, s6, 1
s_cmp_lt_u32 s14, 1
s_cbranch_scc1 L_pp0
s_cmp_lg_u32 s6, 0
s_waitcnt vmcnt(0) lgkmcnt(0)
v_smfmac_f32_16x16x64_bf16 v[16:19], v[24:27], v[28:35], v11
v_smfmac_f32_16x16x64_bf16 v[20:23], v[24:27], v[36:43], v11
s_cbranch_scc1 L_loop
s_branch L_store
L_pp0:
s_waitcnt lgkmcnt(0)
v_readlane_b32 s7, v8, 63
s_sub_u32 s7, s7, s4
s_bfe_u32 s7, s7, 327698
s_bitcmp1_b32 0xfff80000, s7
s_cbranch_scc1 L_ph0
s_setprio 3
s_bitcmp1_b32 0xf807fc00, s7
s_cbranch_scc0 L_pe0
s_setprio 2
s_branch L_pe0
L_ph0:
s_setprio 1
s_bitcmp1_b32 0xf807fc00, s7
s_cbranch_scc0 L_pe0
s_setprio 0
L_pe0:
v_add_u32_dpp v12, v8, v2 row_newbcast:0 row_mask:0xf bank_mask:0xf
buffer_load_dword v44, v12, s[16:19], 0 offen
buffer_load_dword v52, v12, s[16:19], 0 offen offset:64
v_add_u32_dpp v13, v8, v2 row_newbcast:1 row_mask:0xf bank_mask:0xf
buffer_load_dword v45, v13, s[16:19], 0 offen
buffer_load_dword v53, v13, s[16:19], 0 offen offset:64
v_add_u32_dpp v12, v8, v2 row_newbcast:2 row_mask:0xf bank_mask:0xf
buffer_load_dword v46, v12, s[16:19], 0 offen
buffer_load_dword v54, v12, s[16:19], 0 offen offset:64
v_add_u32_dpp v13, v8, v2 row_newbcast:3 row_mask:0xf bank_mask:0xf
buffer_load_dword v47, v13, s[16:19], 0 offen
buffer_load_dword v55, v13, s[16:19], 0 offen offset:64
v_add_u32_dpp v12, v8, v2 row_newbcast:4 row_mask:0xf bank_mask:0xf
buffer_load_dword v48, v12, s[16:19], 0 offen
buffer_load_dword v56, v12, s[16:19], 0 offen offset:64
v_add_u32_dpp v13, v8, v2 row_newbcast:5 row_mask:0xf bank_mask:0xf
buffer_load_dword v49, v13, s[16:19], 0 offen
buffer_load_dword v57, v13, s[16:19], 0 offen offset:64
v_add_u32_dpp v12, v8, v2 row_newbcast:6 row_mask:0xf bank_mask:0xf
buffer_load_dword v50, v12, s[16:19], 0 offen
buffer_load_dword v58, v12, s[16:19], 0 offen offset:64
v_add_u32_dpp v13, v8, v2 row_newbcast:7 row_mask:0xf bank_mask:0xf
buffer_load_dword v51, v13, s[16:19], 0 offen
buffer_load_dword v59, v13, s[16:19], 0 offen offset:64
v_add_u32_sdwa v6, v3, v9 dst_sel:DWORD dst_unused:UNUSED_PAD src0_sel:DWORD src1_sel:WORD_1
ds_write_b16 v6, v9
ds_read_b128 v[60:63], v5
s_waitcnt vmcnt(16)
v_smfmac_f32_16x16x64_bf16 v[16:19], v[24:27], v[28:35], v11
v_smfmac_f32_16x16x64_bf16 v[20:23], v[24:27], v[36:43], v11
s_waitcnt vmcnt(0) lgkmcnt(0)
v_smfmac_f32_16x16x64_bf16 v[16:19], v[60:63], v[44:51], v11
v_smfmac_f32_16x16x64_bf16 v[20:23], v[60:63], v[52:59], v11
L_store:
v_and_b32 v2, 31, v1
v_and_b32 v6, 32, v1
v_lshlrev_b32 v2, 2, v2
v_lshl_add_u32 v6, v6, 4, v2
s_lshl_b32 s7, s5, 10
s_nop 7
v_cvt_pk_bf16_f32 v24, v16, v17
v_cvt_pk_bf16_f32 v25, v18, v19
v_cvt_pk_bf16_f32 v26, v20, v21
v_cvt_pk_bf16_f32 v27, v22, v23
s_nop 1
v_permlane16_swap_b32 v24, v26
v_permlane16_swap_b32 v25, v27
buffer_store_dword v24, v6, s[20:23], s7 offen offset:0 nt
buffer_store_dword v25, v6, s[20:23], s7 offen offset:128 nt
buffer_store_dword v26, v6, s[20:23], s7 offen offset:256 nt
buffer_store_dword v27, v6, s[20:23], s7 offen offset:384 nt
L_end:
s_endpgm
.section .rodata,"a"
.p2align 6
.amdhsa_kernel standalone__sparse_matmul_formats_ell__sparse_mat_kernel
  .amdhsa_next_free_vgpr 64
  .amdhsa_next_free_sgpr 74
  .amdhsa_accum_offset 64
  .amdhsa_group_segment_fixed_size 0
  .amdhsa_kernarg_size 48
  .amdhsa_user_sgpr_count 2
  .amdhsa_user_sgpr_kernarg_segment_ptr 1
  .amdhsa_system_sgpr_workgroup_id_x 1
.end_amdhsa_kernel
```
